```python
import torch

def _softmax(x, axis=-1):
    return torch.softmax(x, dim=axis)
def _gelu(x):
    return torch.nn.functional.gelu(x, approximate="tanh")
def _silu(x):
    return torch.nn.functional.silu(x)
def _sigmoid(x):
    return torch.sigmoid(x)
def _layernorm(x, axis=-1, eps=1e-5):
    m = x.mean(dim=axis, keepdim=True)
    v = x.var(dim=axis, keepdim=True, unbiased=False)
    return (x - m) / torch.sqrt(v + eps)
def _scatter_add(tgt, idx, src, axis=0):
    return tgt.clone().index_add_(axis, idx, src)
def _segment_sum(src, seg, n):
    out = torch.zeros((n,) + src.shape[1:], dtype=src.dtype)
    return out.index_add_(0, seg, src)
def _pad(x, pw):
    flat = tuple(v for pair in reversed(pw) for v in pair)
    return torch.nn.functional.pad(x, flat)

kernel_name = 'gather_scatter__edge_featured_mpnn_egc__graph'

def setup_inputs():

    _w = (lambda a: (lambda t: t.to(torch.bfloat16) if t.is_floating_point() else t)(torch.as_tensor(a)))
    N, deg, D, De = 25000, 16, 128, max(16, 1)
    E = N * deg
    return {
        "x": _w((lambda *s: torch.randn(*s, dtype=torch.bfloat16) * 0.2)(N, D)),
        "e_attr": _w((lambda *s: torch.randn(*s, dtype=torch.bfloat16) * 0.2)(E, De)),
        "src": _w((lambda lo, hi, *s: torch.randint(lo, hi, s))(0, N, E).to(torch.int64)),
        "dst": _w((lambda lo, hi, *s: torch.randint(lo, hi, s))(0, N, E).to(torch.int64)),
        "u_w": _w((lambda *s: torch.randn(*s, dtype=torch.bfloat16) * 0.05)(D, D)),
        "v_w": _w((lambda *s: torch.randn(*s, dtype=torch.bfloat16) * 0.05)(D, D)),
        "g_w": _w((lambda *s: torch.randn(*s, dtype=torch.bfloat16) * 0.2)(2 * D + De, D)),
    }

def reference(x, e_attr, src, dst, u_w, v_w, g_w):
    N, D = x.shape
    g_in = torch.concatenate([x[dst], x[src], e_attr], axis=-1)
    eta = _sigmoid(g_in @ g_w)
    hv = x @ v_w
    msg = eta * hv[src]
    agg = _segment_sum(msg, dst, N)
    return _silu(x @ u_w + agg)
```

```asm
; @launch grid=(256,1,1) block=(1024,1,1) lds=156416
.amdgcn_target "amdgcn-amd-amdhsa--gfx950"
.text
.globl gather_scatter__edge_featured_mpnn_egc__graph_kernel
.p2align 8
.type gather_scatter__edge_featured_mpnn_egc__graph_kernel,@function
gather_scatter__edge_featured_mpnn_egc__graph_kernel:
  s_cmp_ge_u32 s2, 256
  s_cbranch_scc1 K2_exit
  s_load_dwordx4 s[4:7], s[0:1], 0
  s_load_dwordx4 s[64:67], s[0:1], 16
  s_load_dwordx4 s[28:31], s[0:1], 32
  s_load_dwordx4 s[48:51], s[0:1], 48
  s_load_dwordx4 s[80:83], s[0:1], 64
  s_memrealtime s[58:59]
  v_lshrrev_b32 v2, 6, v0
  v_and_b32 v108, 63, v0
  v_readfirstlane_b32 s20, v2
  v_mov_b32 v109, v0
  s_mul_i32 s45, s2, 6400
  v_lshlrev_b32 v4, 4, v0
  v_add_u32 v5, s45, v4
  v_cmp_gt_u32 vcc, 400, v0
  s_cmp_lt_u32 s2, 250
  s_cselect_b64 s[78:79], vcc, 0
  s_waitcnt lgkmcnt(0)
  s_mov_b32 s68, s66
  s_mov_b32 s69, s67
  s_mov_b32 s66, 1600000
  s_mov_b32 s67, 0x20000
  s_mov_b32 s70, 1600000
  s_mov_b32 s71, 0x20000
  s_mov_b64 exec, s[78:79]
  s_cbranch_execz F_noload
  buffer_load_dwordx4 v[8:11], v5, s[68:71], 0 offen
  buffer_load_dwordx4 v[12:15], v5, s[64:67], 0 offen
F_noload:
  s_mov_b64 exec, -1
  s_mov_b32 s12, s6
  s_mov_b32 s13, s7
  s_mov_b32 s56, s82
  s_mov_b32 s57, s83
  s_mov_b32 s76, s28
  s_mov_b32 s77, s29
  s_mov_b32 s82, 256
  s_mov_b32 s83, 0x20000
  s_or_b32 s3, s58, 1
  v_mov_b32 v6, 0
  v_mov_b32 v7, s3
  s_add_u32 s45, s2, s20
  s_cmp_lg_u32 s45, 0
  s_cbranch_scc1 F_nononce
  s_mov_b64 exec, 1
  buffer_store_dword v7, v6, s[80:83], 0 offen sc1
  s_mov_b64 exec, -1
F_nononce:
  s_mov_b32 s6, 6400000
  s_mov_b32 s7, 0x20000
  s_add_u32 s24, s48, 32768
  s_addc_u32 s25, s49, 0
  s_mov_b32 s26, 32768
  s_mov_b32 s27, 0x20000
  s_mov_b32 s28, s30
  s_mov_b32 s29, s31
  s_mov_b32 s30, 32768
  s_mov_b32 s31, 0x20000
  v_lshrrev_b32 v16, 4, v108
  v_and_b32 v17, 15, v108
  s_and_b32 s45, s20, 3
  s_lshl_b32 s45, s45, 3
  v_add_u32 v16, s45, v16
  s_lshr_b32 s45, s20, 2
  s_mul_i32 s47, s2, 98
  s_add_u32 s47, s47, s45
  s_lshl_b32 s46, s20, 11
  s_add_u32 s46, s46, 69632
  s_sub_u32 s45, 98, s45
  v_and_b32 v18, 15, v16
  v_xor_b32 v18, v18, v17
  v_lshlrev_b32 v19, 2, v16
  v_cmp_gt_u32 vcc, s45, v19
  v_add_u32 v19, s47, v19
  v_lshlrev_b32 v19, 8, v19
  v_lshl_add_u32 v18, v18, 4, v19
  s_mov_b32 m0, s46
  v_mov_b32 v19, 0x7fff0000
  v_cndmask_b32 v18, v19, v18, vcc
  s_add_u32 s46, s46, 1024
  buffer_load_dwordx4 v18, s[4:7], 0 offen lds
  v_add_u32 v16, 4, v16
  v_and_b32 v18, 15, v16
  v_xor_b32 v18, v18, v17
  v_lshlrev_b32 v19, 2, v16
  v_cmp_gt_u32 vcc, s45, v19
  v_add_u32 v19, s47, v19
  v_lshlrev_b32 v19, 8, v19
  v_lshl_add_u32 v18, v18, 4, v19
  s_mov_b32 m0, s46
  v_mov_b32 v19, 0x7fff0000
  v_cndmask_b32 v18, v19, v18, vcc
  s_add_u32 s46, s46, 1024
  buffer_load_dwordx4 v18, s[4:7], 0 offen lds
  v_lshrrev_b32 v16, 4, v108
  v_and_b32 v17, 15, v108
  v_lshlrev_b32 v18, 2, v16
  v_xor_b32 v18, v18, v17
  v_lshlrev_b32 v18, 4, v18
  v_lshl_add_u32 v18, v16, 8, v18
  s_lshl_b32 s44, s20, 11
  v_add_u32 v18, s44, v18
  s_add_u32 s44, s44, 4096
  s_mov_b32 m0, s44
  s_add_u32 s44, s44, 32768
  buffer_load_dwordx4 v18, s[24:27], 0 offen lds
  buffer_load_dwordx4 v18, s[24:27], 0 offen offset:1024 lds
  s_mov_b32 m0, s44
  s_nop 0
  buffer_load_dwordx4 v18, s[28:31], 0 offen lds
  buffer_load_dwordx4 v18, s[28:31], 0 offen offset:1024 lds
  v_mov_b32 v2, v18
  s_add_u32 s84, s48, 65536
  s_addc_u32 s85, s49, 0
  s_mov_b32 s86, 4096
  s_mov_b32 s87, 0x20000
  s_cmp_lt_u32 s20, 12
  s_cbranch_scc1 F_nocs
  s_and_b32 s44, s20, 3
  s_lshl_b32 s44, s44, 10
  v_and_b32 v18, 0x3ff, v18
  v_add_u32 v18, s44, v18
  s_add_u32 s44, s44, 152320
  s_mov_b32 m0, s44
  s_nop 0
  buffer_load_dwordx4 v18, s[84:87], 0 offen lds
F_nocs:
  s_mov_b32 s14, 12800000
  s_mov_b32 s15, 0x20000
  s_add_u32 s32, s56, 37748736
  s_addc_u32 s33, s57, 0
  s_mov_b32 s34, 3200000
  s_mov_b32 s35, 0x20000
  s_add_u32 s36, s56, 41943040
  s_addc_u32 s37, s57, 0
  s_mov_b32 s38, 524288
  s_mov_b32 s39, 0x20000
  s_mov_b32 s52, s50
  s_mov_b32 s53, s51
  s_mov_b32 s54, 6400000
  s_mov_b32 s55, 0x20000
  s_add_u32 s72, s56, 1048576
  s_addc_u32 s73, s57, 0
  s_mov_b32 s74, 12800000
  s_mov_b32 s75, 0x20000
  s_and_b32 s46, s20, 3
  s_lshl_b32 s44, s46, 7
  s_add_u32 s44, s44, 1048448
  s_add_u32 s8, s56, s44
  s_addc_u32 s9, s57, 0
  s_or_b32 s9, s9, 0x40000
  s_mov_b32 s10, 12800128
  s_mov_b32 s11, 0x800000
  v_lshrrev_b32 v16, 5, v108
  v_lshlrev_b32 v118, 4, v16
  v_and_b32 v17, 31, v108
  s_mul_i32 s19, s20, 2080
  s_add_u32 s19, s19, 102400
  s_movk_i32 s17, 80
  s_mov_b32 s18, 0xffffffe0
  v_mad_u32_u24 v120, v17, s17, v118
  v_add_u32 v120, s19, v120
  v_and_b32 v19, 19, v17
  v_and_b32 v20, 4, v17
  v_lshl_add_u32 v19, v20, 1, v19
  v_and_b32 v20, 8, v17
  v_lshrrev_b32 v20, 1, v20
  v_add_u32 v19, v19, v20
  v_lshlrev_b32 v19, 1, v19
  v_add_u32 v119, s19, v19
  v_mov_b32 v121, 0x3f800000
  v_lshlrev_b32 v122, 2, v17
  v_add_u32 v122, 8064, v122
  v_lshlrev_b32 v123, 4, v108
  v_mov_b32 v24, 0
  v_mov_b32 v25, 0
  v_mov_b32 v26, 0
  v_mov_b32 v27, 0
  s_cmp_lg_u32 s20, 7
  s_cbranch_scc1 F_noinit
  v_lshlrev_b32 v20, 4, v108
  v_add_u32 v21, 102400, v20
  ds_write_b128 v21, v[24:27]
  ds_write_b128 v20, v[24:27]
  ds_write_b128 v20, v[24:27] offset:1024
  ds_write_b128 v20, v[24:27] offset:2048
  v_mad_u32_u24 v20, v17, s17, v19
  ds_write_b16_d16_hi v20, v121 offset:0
  s_waitcnt lgkmcnt(0)
F_noinit:
  s_mov_b32 s60, 1
  s_barrier
  s_mov_b64 exec, s[78:79]
  s_cbranch_execz F_norank
  s_mov_b32 s44, 87652394
  s_movk_i32 s45, 98
  s_movk_i32 s46, 512
  s_mul_i32 s47, s2, 1600
  v_lshl_add_u32 v3, v0, 2, s47
  v_lshlrev_b32 v3, 5, v3
  v_mov_b32 v7, 1
  s_waitcnt vmcnt(6)
  v_lshrrev_b32 v16, 1, v8
  v_mul_hi_u32 v16, v16, s44
  v_mul_u32_u24 v17, s45, v16
  v_sub_u32 v17, v8, v17
  v_and_b32 v18, 7, v16
  v_bfe_u32 v16, v16, 3, 5
  v_lshl_add_u32 v16, v18, 5, v16
  v_lshlrev_b32 v8, 2, v16
  v_add_u32 v16, 102400, v8
  ds_add_rtn_u32 v20, v16, v7
  v_lshrrev_b32 v16, 2, v17
  v_add3_u32 v41, v3, v16, 0
  v_and_b32 v17, 3, v17
  v_mul_u32_u24 v16, 42949, v12
  v_bfe_u32 v16, v16, 26, 4
  v_lshl_add_u32 v16, v17, 4, v16
  v_mul_u32_u24 v17, s46, v12
  v_lshl_or_b32 v40, v16, 26, v17
  v_lshrrev_b32 v16, 1, v9
  v_mul_hi_u32 v16, v16, s44
  v_mul_u32_u24 v17, s45, v16
  v_sub_u32 v17, v9, v17
  v_and_b32 v18, 7, v16
  v_bfe_u32 v16, v16, 3, 5
  v_lshl_add_u32 v16, v18, 5, v16
  v_lshlrev_b32 v9, 2, v16
  v_add_u32 v16, 102400, v9
  ds_add_rtn_u32 v21, v16, v7
  v_lshrrev_b32 v16, 2, v17
  v_add3_u32 v43, v3, v16, 32
  v_and_b32 v17, 3, v17
  v_mul_u32_u24 v16, 42949, v13
  v_bfe_u32 v16, v16, 26, 4
  v_lshl_add_u32 v16, v17, 4, v16
  v_mul_u32_u24 v17, s46, v13
  v_lshl_or_b32 v42, v16, 26, v17
  v_lshrrev_b32 v16, 1, v10
  v_mul_hi_u32 v16, v16, s44
  v_mul_u32_u24 v17, s45, v16
  v_sub_u32 v17, v10, v17
  v_and_b32 v18, 7, v16
  v_bfe_u32 v16, v16, 3, 5
  v_lshl_add_u32 v16, v18, 5, v16
  v_lshlrev_b32 v10, 2, v16
  v_add_u32 v16, 102400, v10
  ds_add_rtn_u32 v22, v16, v7
  v_lshrrev_b32 v16, 2, v17
  v_add3_u32 v45, v3, v16, 64
  v_and_b32 v17, 3, v17
  v_mul_u32_u24 v16, 42949, v14
  v_bfe_u32 v16, v16, 26, 4
  v_lshl_add_u32 v16, v17, 4, v16
  v_mul_u32_u24 v17, s46, v14
  v_lshl_or_b32 v44, v16, 26, v17
  v_lshrrev_b32 v16, 1, v11
  v_mul_hi_u32 v16, v16, s44
  v_mul_u32_u24 v17, s45, v16
  v_sub_u32 v17, v11, v17
  v_and_b32 v18, 7, v16
  v_bfe_u32 v16, v16, 3, 5
  v_lshl_add_u32 v16, v18, 5, v16
  v_lshlrev_b32 v11, 2, v16
  v_add_u32 v16, 102400, v11
  ds_add_rtn_u32 v23, v16, v7
  v_lshrrev_b32 v16, 2, v17
  v_add3_u32 v47, v3, v16, 64
  v_and_b32 v17, 3, v17
  v_mul_u32_u24 v16, 42949, v15
  v_bfe_u32 v16, v16, 26, 4
  v_lshl_add_u32 v16, v17, 4, v16
  v_mul_u32_u24 v17, s46, v15
  v_lshl_or_b32 v46, v16, 26, v17
  v_add_u32 v47, 32, v47
F_norank:
  s_mov_b64 exec, -1
  v_mov_b32 v6, 0
  s_waitcnt vmcnt(0) lgkmcnt(0)
  s_barrier
  buffer_load_dword v7, v6, s[80:83], 0 offen sc1
  s_mov_b32 s24, s48
  s_mov_b32 s25, s49
  s_mov_b32 s26, 32768
  s_mov_b32 s27, 0x20000
  s_mov_b32 s28, s76
  s_mov_b32 s29, s77
  s_mov_b32 s30, 32768
  s_mov_b32 s31, 0x20000
  buffer_load_dwordx4 v[88:91], v2, s[24:27], 0 offen offset:0
  buffer_load_dwordx4 v[92:95], v2, s[24:27], 0 offen offset:1024
  buffer_load_dwordx4 v[96:99], v2, s[28:31], 0 offen offset:0
  buffer_load_dwordx4 v[100:103], v2, s[28:31], 0 offen offset:1024
  s_cmp_ge_u32 s20, 7
  s_cbranch_scc1 F_noscan
  v_lshlrev_b32 v16, 4, v108
  v_add_u32 v17, 102400, v16
  ds_read_b128 v[24:27], v17
  s_lshl_b32 s44, s20, 10
  s_add_u32 s44, s44, 103424
  s_waitcnt lgkmcnt(0)
  v_add_u32 v29, v24, v25
  v_add_u32 v30, v29, v26
  v_add_u32 v31, v30, v27
  v_mov_b32 v32, v31
  s_nop 1
  v_add_u32_dpp v32, v32, v32 row_shr:1 row_mask:0xf bank_mask:0xf bound_ctrl:0
  s_nop 1
  v_add_u32_dpp v32, v32, v32 row_shr:2 row_mask:0xf bank_mask:0xf bound_ctrl:0
  s_nop 1
  v_add_u32_dpp v32, v32, v32 row_shr:4 row_mask:0xf bank_mask:0xf bound_ctrl:0
  s_nop 1
  v_add_u32_dpp v32, v32, v32 row_shr:8 row_mask:0xf bank_mask:0xf bound_ctrl:0
  s_nop 1
  v_add_u32_dpp v32, v32, v32 row_bcast:15 row_mask:0xa bank_mask:0xf
  s_nop 1
  v_add_u32_dpp v32, v32, v32 row_bcast:31 row_mask:0xc bank_mask:0xf
  s_nop 1
  v_sub_u32 v32, v32, v31
  v_add_u32 v33, v32, v24
  v_add_u32 v34, v32, v29
  v_add_u32 v35, v32, v30
  v_add_u32 v17, s44, v16
  ds_write_b128 v17, v[32:35]
  v_lshl_or_b32 v80, v24, 16, v32
  v_lshl_or_b32 v82, v25, 16, v33
  v_lshl_or_b32 v84, v26, 16, v34
  v_lshl_or_b32 v86, v27, 16, v35
  s_mov_b64 exec, s[78:79]
  v_add_u32 v16, s44, v8
  ds_read_b32 v36, v16
  v_add_u32 v16, s44, v9
  ds_read_b32 v37, v16
  v_add_u32 v16, s44, v10
  ds_read_b32 v38, v16
  v_add_u32 v16, s44, v11
  ds_read_b32 v39, v16
  s_waitcnt lgkmcnt(0)
  v_add_u32 v16, v36, v20
  v_lshlrev_b32 v16, 3, v16
  v_add_u32 v16, 110592, v16
  ds_write_b64 v16, v[40:41]
  v_add_u32 v16, v37, v21
  v_lshlrev_b32 v16, 3, v16
  v_add_u32 v16, 110592, v16
  ds_write_b64 v16, v[42:43]
  v_add_u32 v16, v38, v22
  v_lshlrev_b32 v16, 3, v16
  v_add_u32 v16, 110592, v16
  ds_write_b64 v16, v[44:45]
  v_add_u32 v16, v39, v23
  v_lshlrev_b32 v16, 3, v16
  v_add_u32 v16, 110592, v16
  ds_write_b64 v16, v[46:47]
  s_mov_b64 exec, -1
F_noscan:
  s_lshr_b32 s46, s20, 2
  s_and_b32 s47, s20, 3
  v_and_b32 v8, 31, v108
  v_lshrrev_b32 v9, 5, v108
  v_and_b32 v10, 15, v8
  v_xor_b32 v10, v10, v9
  v_lshlrev_b32 v10, 4, v10
  v_lshl_add_u32 v8, v8, 8, v10
  s_lshl_b32 s44, s46, 13
  s_add_u32 s44, s44, 69632
  v_add_u32 v8, s44, v8
  v_bfe_u32 v10, v108, 2, 2
  v_lshl_add_u32 v9, v9, 3, v10
  v_lshlrev_b32 v9, 8, v9
  v_lshlrev_b32 v10, 2, v10
  s_lshl_b32 s44, s47, 2
  v_xor_b32 v10, s44, v10
  v_lshl_add_u32 v9, v10, 4, v9
  v_bfe_u32 v10, v108, 4, 1
  v_lshl_add_u32 v9, v10, 5, v9
  v_and_b32 v10, 3, v108
  v_lshl_add_u32 v9, v10, 3, v9
  v_add_u32 v9, 4096, v9
  ds_read_b128 v[24:27], v8
  ds_read_b64_tr_b16 v[32:33], v9 offset:0
  ds_read_b64_tr_b16 v[34:35], v9 offset:1024
  ds_read_b64_tr_b16 v[36:37], v9 offset:32768
  ds_read_b64_tr_b16 v[38:39], v9 offset:33792
  v_xor_b32 v10, 32, v8
  ds_read_b128 v[28:31], v10
  ds_read_b64_tr_b16 v[40:41], v9 offset:4096
  ds_read_b64_tr_b16 v[42:43], v9 offset:5120
  ds_read_b64_tr_b16 v[44:45], v9 offset:36864
  ds_read_b64_tr_b16 v[46:47], v9 offset:37888
  s_waitcnt lgkmcnt(5)
  v_mfma_f32_32x32x16_bf16 v[48:63], v[24:27], v[32:35], 0
  v_mfma_f32_32x32x16_bf16 v[64:79], v[24:27], v[36:39], 0
  v_xor_b32 v10, 64, v8
  ds_read_b128 v[24:27], v10
  ds_read_b64_tr_b16 v[32:33], v9 offset:8192
  ds_read_b64_tr_b16 v[34:35], v9 offset:9216
  ds_read_b64_tr_b16 v[36:37], v9 offset:40960
  ds_read_b64_tr_b16 v[38:39], v9 offset:41984
  s_waitcnt lgkmcnt(5)
  v_mfma_f32_32x32x16_bf16 v[48:63], v[28:31], v[40:43], v[48:63]
  v_mfma_f32_32x32x16_bf16 v[64:79], v[28:31], v[44:47], v[64:79]
  v_xor_b32 v10, 96, v8
  ds_read_b128 v[28:31], v10
  ds_read_b64_tr_b16 v[40:41], v9 offset:12288
  ds_read_b64_tr_b16 v[42:43], v9 offset:13312
  ds_read_b64_tr_b16 v[44:45], v9 offset:45056
  ds_read_b64_tr_b16 v[46:47], v9 offset:46080
  s_waitcnt lgkmcnt(5)
  v_mfma_f32_32x32x16_bf16 v[48:63], v[24:27], v[32:35], v[48:63]
  v_mfma_f32_32x32x16_bf16 v[64:79], v[24:27], v[36:39], v[64:79]
  v_xor_b32 v10, 128, v8
  ds_read_b128 v[24:27], v10
  ds_read_b64_tr_b16 v[32:33], v9 offset:16384
  ds_read_b64_tr_b16 v[34:35], v9 offset:17408
  ds_read_b64_tr_b16 v[36:37], v9 offset:49152
  ds_read_b64_tr_b16 v[38:39], v9 offset:50176
  s_waitcnt lgkmcnt(5)
  v_mfma_f32_32x32x16_bf16 v[48:63], v[28:31], v[40:43], v[48:63]
  v_mfma_f32_32x32x16_bf16 v[64:79], v[28:31], v[44:47], v[64:79]
  v_xor_b32 v10, 160, v8
  ds_read_b128 v[28:31], v10
  ds_read_b64_tr_b16 v[40:41], v9 offset:20480
  ds_read_b64_tr_b16 v[42:43], v9 offset:21504
  ds_read_b64_tr_b16 v[44:45], v9 offset:53248
  ds_read_b64_tr_b16 v[46:47], v9 offset:54272
  s_waitcnt lgkmcnt(5)
  v_mfma_f32_32x32x16_bf16 v[48:63], v[24:27], v[32:35], v[48:63]
  v_mfma_f32_32x32x16_bf16 v[64:79], v[24:27], v[36:39], v[64:79]
  v_xor_b32 v10, 192, v8
  ds_read_b128 v[24:27], v10
  ds_read_b64_tr_b16 v[32:33], v9 offset:24576
  ds_read_b64_tr_b16 v[34:35], v9 offset:25600
  ds_read_b64_tr_b16 v[36:37], v9 offset:57344
  ds_read_b64_tr_b16 v[38:39], v9 offset:58368
  s_waitcnt lgkmcnt(5)
  v_mfma_f32_32x32x16_bf16 v[48:63], v[28:31], v[40:43], v[48:63]
  v_mfma_f32_32x32x16_bf16 v[64:79], v[28:31], v[44:47], v[64:79]
  v_xor_b32 v10, 224, v8
  ds_read_b128 v[28:31], v10
  ds_read_b64_tr_b16 v[40:41], v9 offset:28672
  ds_read_b64_tr_b16 v[42:43], v9 offset:29696
  ds_read_b64_tr_b16 v[44:45], v9 offset:61440
  ds_read_b64_tr_b16 v[46:47], v9 offset:62464
  s_waitcnt lgkmcnt(5)
  v_mfma_f32_32x32x16_bf16 v[48:63], v[24:27], v[32:35], v[48:63]
  v_mfma_f32_32x32x16_bf16 v[64:79], v[24:27], v[36:39], v[64:79]
  s_waitcnt lgkmcnt(0)
  v_mfma_f32_32x32x16_bf16 v[48:63], v[28:31], v[40:43], v[48:63]
  v_mfma_f32_32x32x16_bf16 v[64:79], v[28:31], v[44:47], v[64:79]
  s_setprio 2
  s_mov_b32 s44, 400000
F_nonce_poll:
  s_waitcnt vmcnt(0)
F_nonce_chk:
  v_readfirstlane_b32 s61, v7
  s_sub_u32 s44, s44, 1
  s_cbranch_scc1 F_nonce_ok
  s_cmp_lg_u32 s61, 0
  s_cbranch_scc1 F_nonce_ok
  buffer_load_dword v7, v6, s[80:83], 0 offen sc1
  s_branch F_nonce_poll
F_nonce_ok:
  s_mul_i32 s44, s2, 98
  s_add_u32 s44, s44, s46
  s_mul_i32 s44, s44, 512
  s_lshl_b32 s45, s47, 7
  s_add_u32 s44, s44, s45
  v_mul_u32_u24 v11, 512, v118
  v_and_b32 v12, 31, v108
  v_lshl_add_u32 v11, v12, 2, v11
  v_add_u32 v11, s44, v11
  s_mov_b32 s45, 0xbfb82a97
  s_nop 1
  v_mul_f32 v48, s45, v48
  v_cvt_pk_bf16_f32 v48, v64, v48
  buffer_store_dword v48, v11, s[72:75], 0 offen sc1
  v_mul_f32 v49, s45, v49
  v_cvt_pk_bf16_f32 v49, v65, v49
  v_add_u32 v11, 2048, v11
  buffer_store_dword v49, v11, s[72:75], 0 offen sc1
  v_mul_f32 v50, s45, v50
  v_cvt_pk_bf16_f32 v50, v66, v50
  v_add_u32 v11, 2048, v11
  buffer_store_dword v50, v11, s[72:75], 0 offen sc1
  v_mul_f32 v51, s45, v51
  v_cvt_pk_bf16_f32 v51, v67, v51
  v_add_u32 v11, 2048, v11
  buffer_store_dword v51, v11, s[72:75], 0 offen sc1
  v_mul_f32 v52, s45, v52
  v_cvt_pk_bf16_f32 v52, v68, v52
  v_add_u32 v11, 10240, v11
  buffer_store_dword v52, v11, s[72:75], 0 offen sc1
  v_mul_f32 v53, s45, v53
  v_cvt_pk_bf16_f32 v53, v69, v53
  v_add_u32 v11, 2048, v11
  buffer_store_dword v53, v11, s[72:75], 0 offen sc1
  v_mul_f32 v54, s45, v54
  v_cvt_pk_bf16_f32 v54, v70, v54
  v_add_u32 v11, 2048, v11
  buffer_store_dword v54, v11, s[72:75], 0 offen sc1
  v_mul_f32 v55, s45, v55
  v_cvt_pk_bf16_f32 v55, v71, v55
  v_add_u32 v11, 2048, v11
  buffer_store_dword v55, v11, s[72:75], 0 offen sc1
  v_mul_f32 v56, s45, v56
  v_cvt_pk_bf16_f32 v56, v72, v56
  v_add_u32 v11, 10240, v11
  buffer_store_dword v56, v11, s[72:75], 0 offen sc1
  v_mul_f32 v57, s45, v57
  v_cvt_pk_bf16_f32 v57, v73, v57
  v_add_u32 v11, 2048, v11
  buffer_store_dword v57, v11, s[72:75], 0 offen sc1
  v_mul_f32 v58, s45, v58
  v_cvt_pk_bf16_f32 v58, v74, v58
  v_add_u32 v11, 2048, v11
  buffer_store_dword v58, v11, s[72:75], 0 offen sc1
  v_mul_f32 v59, s45, v59
  v_cvt_pk_bf16_f32 v59, v75, v59
  v_add_u32 v11, 2048, v11
  buffer_store_dword v59, v11, s[72:75], 0 offen sc1
  v_mul_f32 v60, s45, v60
  v_cvt_pk_bf16_f32 v60, v76, v60
  v_add_u32 v11, 10240, v11
  s_cmp_ge_u32 s46, 2
  s_cbranch_scc1 F_q
  s_mov_b32 exec_hi, 0
  buffer_store_dword v60, v11, s[72:75], 0 offen sc1
F_q:
  s_setprio 0
  s_mov_b64 exec, -1
  s_barrier
  s_lshl_b32 s44, s20, 11
  s_add_u32 s44, s44, 4096
  v_lshl_add_u32 v16, v108, 4, s44
  ds_write_b128 v16, v[88:91]
  ds_write_b128 v16, v[92:95] offset:1024
  ds_write_b128 v16, v[96:99] offset:32768
  ds_write_b128 v16, v[100:103] offset:33792
  v_cmp_gt_u32 vcc, 800, v109
  s_cmp_lt_u32 s2, 250
  s_cselect_b64 s[46:47], vcc, 0
  s_mov_b64 exec, s[46:47]
  s_cbranch_execz F_noent
  v_add_u32 v16, 110592, v4
  ds_read_b128 v[8:11], v16
  s_mul_i32 s45, s2, 12800
  v_add_u32 v5, s45, v4
  s_waitcnt lgkmcnt(0)
  buffer_store_dwordx4 v[8:11], v5, s[32:35], 0 offen sc1
F_noent:
  s_mov_b64 exec, -1
  s_waitcnt vmcnt(0) lgkmcnt(0)
  s_barrier
  s_cmp_lg_u32 s20, 0
  s_cbranch_scc1 F_nocell
  v_mov_b32 v81, s61
  v_mov_b32 v83, s61
  v_mov_b32 v85, s61
  v_mov_b32 v87, s61
  s_lshl_b32 s45, s2, 11
  v_lshl_add_u32 v16, v108, 5, s45
  buffer_store_dwordx4 v[80:83], v16, s[36:39], 0 offen sc1
  buffer_store_dwordx4 v[84:87], v16, s[36:39], 0 offen offset:16 sc1
F_nocell:
  v_mov_b32 v24, 0
  v_mov_b32 v25, 0
  v_mov_b32 v26, 0
  v_mov_b32 v27, 0
  v_add_u32 v16, 102400, v4
  ds_write_b128 v16, v[24:27]
  ds_write_b128 v16, v[24:27] offset:16384
  v_and_b32 v16, 0x3f0, v4
  v_add_u32 v16, 135168, v16
  ds_write_b128 v16, v[24:27]
  s_and_b32 s44, s2, 7
  s_lshl_b32 s44, s44, 5
  s_lshr_b32 s45, s2, 3
  s_add_u32 s44, s44, s45
  s_lshl_b32 s44, s44, 3
  v_lshrrev_b32 v19, 2, v109
  v_lshl_add_u32 v18, v19, 11, s44
  s_lshr_b32 s46, s20, 2
  s_and_b32 s47, s20, 3
  v_and_b32 v16, 31, v108
  v_lshrrev_b32 v17, 5, v108
  v_and_b32 v22, 15, v16
  v_xor_b32 v22, v22, v17
  v_lshlrev_b32 v22, 4, v22
  v_lshl_add_u32 v16, v16, 8, v22
  s_lshl_b32 s44, s46, 13
  s_add_u32 s44, s44, 69632
  v_add_u32 v16, s44, v16
  v_bfe_u32 v22, v108, 2, 2
  v_lshl_add_u32 v17, v17, 3, v22
  v_lshlrev_b32 v17, 8, v17
  v_lshlrev_b32 v22, 2, v22
  s_lshl_b32 s44, s47, 2
  v_xor_b32 v22, s44, v22
  v_lshl_add_u32 v17, v22, 4, v17
  v_bfe_u32 v22, v108, 4, 1
  v_lshl_add_u32 v17, v22, 5, v17
  v_and_b32 v22, 3, v108
  v_lshl_add_u32 v17, v22, 3, v17
  v_add_u32 v17, 4096, v17
  v_add_u32 v22, 148224, v17
  ds_read_b64_tr_b16 v[88:89], v22 offset:0
  ds_read_b64_tr_b16 v[90:91], v22 offset:1024
  ds_read_b128 v[24:27], v16
  ds_read_b64_tr_b16 v[32:33], v17 offset:0
  ds_read_b64_tr_b16 v[34:35], v17 offset:1024
  ds_read_b64_tr_b16 v[36:37], v17 offset:32768
  ds_read_b64_tr_b16 v[38:39], v17 offset:33792
  v_xor_b32 v22, 32, v16
  ds_read_b128 v[28:31], v22
  ds_read_b64_tr_b16 v[40:41], v17 offset:4096
  ds_read_b64_tr_b16 v[42:43], v17 offset:5120
  ds_read_b64_tr_b16 v[44:45], v17 offset:36864
  ds_read_b64_tr_b16 v[46:47], v17 offset:37888
  s_waitcnt lgkmcnt(5)
  v_mfma_f32_32x32x16_bf16 v[64:79], v[24:27], v[32:35], 0
  v_mfma_f32_32x32x16_bf16 v[0:15], v[24:27], v[36:39], 0
  v_xor_b32 v22, 64, v16
  ds_read_b128 v[24:27], v22
  ds_read_b64_tr_b16 v[32:33], v17 offset:8192
  ds_read_b64_tr_b16 v[34:35], v17 offset:9216
  ds_read_b64_tr_b16 v[36:37], v17 offset:40960
  ds_read_b64_tr_b16 v[38:39], v17 offset:41984
  s_waitcnt lgkmcnt(5)
  v_mfma_f32_32x32x16_bf16 v[64:79], v[28:31], v[40:43], v[64:79]
  v_mfma_f32_32x32x16_bf16 v[0:15], v[28:31], v[44:47], v[0:15]
  v_xor_b32 v22, 96, v16
  ds_read_b128 v[28:31], v22
  ds_read_b64_tr_b16 v[40:41], v17 offset:12288
  ds_read_b64_tr_b16 v[42:43], v17 offset:13312
  ds_read_b64_tr_b16 v[44:45], v17 offset:45056
  ds_read_b64_tr_b16 v[46:47], v17 offset:46080
  s_waitcnt lgkmcnt(5)
  v_mfma_f32_32x32x16_bf16 v[64:79], v[24:27], v[32:35], v[64:79]
  v_mfma_f32_32x32x16_bf16 v[0:15], v[24:27], v[36:39], v[0:15]
  v_xor_b32 v22, 128, v16
  ds_read_b128 v[24:27], v22
  ds_read_b64_tr_b16 v[32:33], v17 offset:16384
  ds_read_b64_tr_b16 v[34:35], v17 offset:17408
  ds_read_b64_tr_b16 v[36:37], v17 offset:49152
  ds_read_b64_tr_b16 v[38:39], v17 offset:50176
  s_waitcnt lgkmcnt(5)
  v_mfma_f32_32x32x16_bf16 v[64:79], v[28:31], v[40:43], v[64:79]
  v_mfma_f32_32x32x16_bf16 v[0:15], v[28:31], v[44:47], v[0:15]
  v_xor_b32 v22, 160, v16
  ds_read_b128 v[28:31], v22
  ds_read_b64_tr_b16 v[40:41], v17 offset:20480
  ds_read_b64_tr_b16 v[42:43], v17 offset:21504
  ds_read_b64_tr_b16 v[44:45], v17 offset:53248
  ds_read_b64_tr_b16 v[46:47], v17 offset:54272
  s_waitcnt lgkmcnt(5)
  v_mfma_f32_32x32x16_bf16 v[64:79], v[24:27], v[32:35], v[64:79]
  v_mfma_f32_32x32x16_bf16 v[0:15], v[24:27], v[36:39], v[0:15]
  v_xor_b32 v22, 192, v16
  ds_read_b128 v[24:27], v22
  ds_read_b64_tr_b16 v[32:33], v17 offset:24576
  ds_read_b64_tr_b16 v[34:35], v17 offset:25600
  ds_read_b64_tr_b16 v[36:37], v17 offset:57344
  ds_read_b64_tr_b16 v[38:39], v17 offset:58368
  s_waitcnt lgkmcnt(5)
  v_mfma_f32_32x32x16_bf16 v[64:79], v[28:31], v[40:43], v[64:79]
  v_mfma_f32_32x32x16_bf16 v[0:15], v[28:31], v[44:47], v[0:15]
  buffer_load_dwordx2 v[20:21], v18, s[36:39], 0 offen sc1
  v_xor_b32 v22, 224, v16
  ds_read_b128 v[28:31], v22
  ds_read_b64_tr_b16 v[40:41], v17 offset:28672
  ds_read_b64_tr_b16 v[42:43], v17 offset:29696
  ds_read_b64_tr_b16 v[44:45], v17 offset:61440
  ds_read_b64_tr_b16 v[46:47], v17 offset:62464
  s_waitcnt lgkmcnt(5)
  v_mfma_f32_32x32x16_bf16 v[64:79], v[24:27], v[32:35], v[64:79]
  v_mfma_f32_32x32x16_bf16 v[0:15], v[24:27], v[36:39], v[0:15]
  s_waitcnt lgkmcnt(0)
  v_mfma_f32_32x32x16_bf16 v[64:79], v[28:31], v[40:43], v[64:79]
  v_mfma_f32_32x32x16_bf16 v[0:15], v[28:31], v[44:47], v[0:15]
  s_mov_b32 s44, 400000
  s_branch F_cell_chk
  s_mov_b32 s44, 400000
F_cell_poll:
  buffer_load_dwordx2 v[20:21], v18, s[36:39], 0 offen sc1
F_cell_chk:
  s_waitcnt vmcnt(0)
  v_cmp_eq_u32 vcc, s61, v21
  s_cmp_eq_u64 vcc, -1
  s_cbranch_scc1 F_cell_ok
  s_sub_u32 s44, s44, 1
  s_cbranch_scc1 F_cell_ok
  s_sleep 1
  s_branch F_cell_poll
F_cell_ok:
  v_cndmask_b32 v21, 0, v20, vcc
  s_branch F_take
K2_round:
  v_mbcnt_lo_u32_b32 v108, -1, 0
  v_mbcnt_hi_u32_b32 v108, -1, v108
  v_lshl_add_u32 v109, s20, 6, v108
  s_barrier
  s_cmp_lg_u32 s20, 7
  s_cbranch_scc1 F_noclr
  v_mov_b32 v24, 0
  v_mov_b32 v25, 0
  v_mov_b32 v26, 0
  v_mov_b32 v27, 0
  v_lshlrev_b32 v20, 4, v108
  v_min_u32 v20, 304, v20
  ds_write_b128 v20, v[24:27] offset:2560
  s_waitcnt lgkmcnt(0)
F_noclr:
  s_barrier
  v_lshrrev_b32 v19, 2, v109
  v_lshlrev_b32 v20, 2, v19
  ds_read_b32 v21, v20 offset:2880
  s_waitcnt lgkmcnt(0)
F_take:
  v_lshrrev_b32 v22, 16, v21
  v_min_u32 v23, 32, v22
  v_and_b32 v21, 0xffff, v21
  v_and_b32 v28, 3, v109
  s_movk_i32 s46, 1600
  v_mad_u32_u24 v30, v19, s46, v21
  v_lshlrev_b32 v27, 1, v28
  v_add_u32 v30, v30, v27
  v_lshlrev_b32 v30, 3, v30
  v_sub_u32 v26, v23, v27
  v_cmp_lt_i32 vcc, 0, v26
  s_cbranch_vccz F_ld_done
  s_mov_b64 exec, vcc
  buffer_load_dwordx4 v[32:35], v30, s[32:35], 0 offen offset:0 sc1
  s_mov_b64 exec, -1
  v_cmp_lt_i32 vcc, 8, v26
  s_cbranch_vccz F_ld_done
  s_mov_b64 exec, vcc
  buffer_load_dwordx4 v[36:39], v30, s[32:35], 0 offen offset:64 sc1
  s_mov_b64 exec, -1
  v_cmp_lt_i32 vcc, 16, v26
  s_cbranch_vccz F_ld_done
  s_mov_b64 exec, vcc
  buffer_load_dwordx4 v[40:43], v30, s[32:35], 0 offen offset:128 sc1
  s_mov_b64 exec, -1
  v_cmp_lt_i32 vcc, 24, v26
  s_cbranch_vccz F_ld_done
  s_mov_b64 exec, vcc
  buffer_load_dwordx4 v[44:47], v30, s[32:35], 0 offen offset:192 sc1
  s_mov_b64 exec, -1
F_ld_done:
  v_mov_b32 v29, 0
  v_cmp_eq_u32 vcc, 0, v28
  s_and_saveexec_b64 s[44:45], vcc
  ds_add_rtn_u32 v30, v29, v23 offset:2816
  s_waitcnt lgkmcnt(0)
  v_add_u32 v30, v30, v23
  v_cmp_ge_u32 vcc, 1856, v30
  s_nop 1
  v_cndmask_b32 v23, 0, v23, vcc
  v_sub_u32 v22, v22, v23
  v_add_u32 v30, v21, v23
  v_lshl_or_b32 v30, v22, 16, v30
  v_lshlrev_b32 v31, 2, v19
  ds_write_b32 v31, v30 offset:2880
  v_cmp_lt_u32 vcc, 0, v22
  s_and_b64 exec, exec, vcc
  v_mov_b32 v30, 1
  ds_write_b32 v29, v30 offset:2820
  s_mov_b64 exec, s[44:45]
  s_nop 4
  v_mov_b32_dpp v23, v23 quad_perm:[0,0,0,0] row_mask:0xf bank_mask:0xf
  v_sub_u32 v23, v23, v27
  v_mov_b32 v29, 1
  s_cmp_eq_u32 s60, 0
  s_cbranch_scc1 F_nofin
  s_mov_b32 s44, 0xbfb8aa3b
  v_lshlrev_b32 v110, 16, v88
  v_and_b32 v111, 0xffff0000, v88
  v_lshlrev_b32 v112, 16, v89
  v_and_b32 v113, 0xffff0000, v89
  v_lshlrev_b32 v114, 16, v90
  v_and_b32 v115, 0xffff0000, v90
  v_lshlrev_b32 v116, 16, v91
  v_and_b32 v117, 0xffff0000, v91
  v_mul_f32 v110, s44, v110
  v_mul_f32 v111, s44, v111
  v_mul_f32 v112, s44, v112
  v_mul_f32 v113, s44, v113
  v_mul_f32 v114, s44, v114
  v_mul_f32 v115, s44, v115
  v_mul_f32 v116, s44, v116
  v_mul_f32 v117, s44, v117
  v_cvt_pk_bf16_f32 v88, v110, v111
  v_cvt_pk_bf16_f32 v89, v112, v113
  v_cvt_pk_bf16_f32 v90, v114, v115
  v_cvt_pk_bf16_f32 v91, v116, v117
  v_mul_f32 v64, s44, v64
  v_mul_f32 v65, s44, v65
  v_mul_f32 v66, s44, v66
  v_mul_f32 v67, s44, v67
  v_mul_f32 v68, s44, v68
  v_mul_f32 v69, s44, v69
  v_mul_f32 v70, s44, v70
  v_mul_f32 v71, s44, v71
  v_mul_f32 v72, s44, v72
  v_mul_f32 v73, s44, v73
  v_mul_f32 v74, s44, v74
  v_mul_f32 v75, s44, v75
  v_mul_f32 v76, s44, v76
  v_mul_f32 v77, s44, v77
  v_mul_f32 v78, s44, v78
  v_mul_f32 v79, s44, v79
  v_cvt_pk_bf16_f32 v80, v64, v65
  v_cvt_pk_bf16_f32 v81, v66, v67
  v_cvt_pk_bf16_f32 v82, v68, v69
  v_cvt_pk_bf16_f32 v83, v70, v71
  v_cvt_pk_bf16_f32 v84, v72, v73
  v_cvt_pk_bf16_f32 v85, v74, v75
  v_cvt_pk_bf16_f32 v86, v76, v77
  v_cvt_pk_bf16_f32 v87, v78, v79
F_nofin:
  v_cmp_lt_i32 s[80:81], 0, v23
  v_cmp_lt_i32 s[82:83], 1, v23
  v_cmp_lt_i32 s[84:85], 8, v23
  v_cmp_lt_i32 s[86:87], 9, v23
  s_mov_b32 s46, 0xffffff
  s_mov_b32 s47, 12799488
  s_waitcnt vmcnt(0)
  s_cmp_eq_u64 s[80:81], 0
  s_cbranch_scc1 F_rk_done
  v_lshrrev_b32 v48, 24, v32
  s_mov_b64 exec, s[80:81]
  ds_add_rtn_u32 v64, v48, v29 offset:2560
  s_mov_b64 exec, -1
  v_and_b32 v32, s46, v32
  v_min_u32 v32, s47, v32
  v_add_u32 v32, 128, v32
  v_lshrrev_b32 v49, 24, v34
  s_mov_b64 exec, s[82:83]
  ds_add_rtn_u32 v65, v49, v29 offset:2560
  s_mov_b64 exec, -1
  v_and_b32 v34, s46, v34
  v_min_u32 v34, s47, v34
  v_add_u32 v34, 128, v34
  s_cmp_eq_u64 s[84:85], 0
  s_cbranch_scc1 F_rk_done
  v_lshrrev_b32 v50, 24, v36
  s_mov_b64 exec, s[84:85]
  ds_add_rtn_u32 v66, v50, v29 offset:2560
  s_mov_b64 exec, -1
  v_and_b32 v36, s46, v36
  v_min_u32 v36, s47, v36
  v_add_u32 v36, 128, v36
  v_lshrrev_b32 v51, 24, v38
  s_mov_b64 exec, s[86:87]
  ds_add_rtn_u32 v67, v51, v29 offset:2560
  s_mov_b64 exec, -1
  v_and_b32 v38, s46, v38
  v_min_u32 v38, s47, v38
  v_add_u32 v38, 128, v38
  v_cmp_lt_i32 vcc, 16, v23
  s_cmp_eq_u64 vcc, 0
  s_cbranch_scc1 F_rk_done
  v_lshrrev_b32 v52, 24, v40
  s_mov_b64 exec, vcc
  ds_add_rtn_u32 v68, v52, v29 offset:2560
  s_mov_b64 exec, -1
  v_and_b32 v40, s46, v40
  v_min_u32 v40, s47, v40
  v_add_u32 v40, 128, v40
  v_cmp_lt_i32 vcc, 17, v23
  v_lshrrev_b32 v53, 24, v42
  s_mov_b64 exec, vcc
  ds_add_rtn_u32 v69, v53, v29 offset:2560
  s_mov_b64 exec, -1
  v_and_b32 v42, s46, v42
  v_min_u32 v42, s47, v42
  v_add_u32 v42, 128, v42
  v_cmp_lt_i32 vcc, 24, v23
  s_cmp_eq_u64 vcc, 0
  s_cbranch_scc1 F_rk_done
  v_lshrrev_b32 v54, 24, v44
  s_mov_b64 exec, vcc
  ds_add_rtn_u32 v70, v54, v29 offset:2560
  s_mov_b64 exec, -1
  v_and_b32 v44, s46, v44
  v_min_u32 v44, s47, v44
  v_add_u32 v44, 128, v44
  v_cmp_lt_i32 vcc, 25, v23
  v_lshrrev_b32 v55, 24, v46
  s_mov_b64 exec, vcc
  ds_add_rtn_u32 v71, v55, v29 offset:2560
  s_mov_b64 exec, -1
  v_and_b32 v46, s46, v46
  v_min_u32 v46, s47, v46
  v_add_u32 v46, 128, v46
F_rk_done:
  s_waitcnt lgkmcnt(0)
  s_barrier
  s_cmp_eq_u32 s60, 0
  s_cbranch_scc1 F_nopf
  s_lshr_b32 s44, s2, 3
  s_lshl_b32 s44, s44, 4
  s_add_u32 s44, s44, s20
  s_mul_i32 s44, s44, 2048
  s_add_u32 s44, s44, 0
  v_lshl_add_u32 v16, v108, 7, s44
  v_cmp_gt_u32 vcc, 16, v108
  s_mov_b64 exec, vcc
  buffer_load_dword v124, v16, s[72:75], 0 offen sc1
  s_mov_b64 exec, -1
F_nopf:
  v_lshlrev_b32 v16, 2, v108
  ds_read_b32 v17, v16 offset:2560
  v_mov_b32 v16, 0
  ds_read_b32 v18, v16 offset:2820
  s_waitcnt lgkmcnt(0)
  v_mov_b32 v20, v17
  v_readfirstlane_b32 s23, v18
  s_nop 1
  v_add_u32_dpp v20, v20, v20 row_shr:1 row_mask:0xf bank_mask:0xf bound_ctrl:0
  s_nop 1
  v_add_u32_dpp v20, v20, v20 row_shr:2 row_mask:0xf bank_mask:0xf bound_ctrl:0
  s_nop 1
  v_add_u32_dpp v20, v20, v20 row_shr:4 row_mask:0xf bank_mask:0xf bound_ctrl:0
  s_nop 1
  v_add_u32_dpp v20, v20, v20 row_shr:8 row_mask:0xf bank_mask:0xf bound_ctrl:0
  s_lshr_b32 s47, s20, 2
  s_lshl_b32 s45, s47, 4
  s_add_u32 s44, s45, 15
  v_add_u32 v21, 31, v20
  v_lshrrev_b32 v21, 5, v21
  v_mov_b32 v18, 0
  v_mov_b32 v22, 0
  v_readlane_b32 s88, v20, s44
  v_mov_b32_dpp v18, v21 row_bcast:15 row_mask:0xa bank_mask:0xf
  v_readlane_b32 s64, v21, s44
  v_add_u32 v16, v21, v18
  v_max_u32 v21, v21, v18
  v_sub_u32 v20, v20, v17
  v_mov_b32_dpp v22, v16 row_bcast:31 row_mask:0xc bank_mask:0xf
  v_readlane_b32 s89, v21, 31
  v_readlane_b32 s90, v21, 63
  v_add_u32 v18, v18, v22
  s_nop 0
  v_readlane_b32 s91, v18, s45
  v_lshl_add_u32 v20, v18, 5, v20
  s_max_u32 s63, s89, s90
  s_mov_b32 s46, 136192
  s_movk_i32 s47, -128
  ds_bpermute_b32 v48, v48, v20
  ds_bpermute_b32 v49, v49, v20
  ds_bpermute_b32 v50, v50, v20
  ds_bpermute_b32 v51, v51, v20
  s_waitcnt lgkmcnt(0)
  v_add_u32 v48, v48, v64
  v_bfe_u32 v16, v48, 2, 1
  v_mad_i32_i24 v32, v16, s47, v32
  v_lshl_add_u32 v48, v48, 2, s46
  s_mov_b64 exec, s[80:81]
  ds_write_b32 v48, v32
  ds_write_b32 v48, v33 offset:8064
  s_mov_b64 exec, -1
  v_add_u32 v49, v49, v65
  v_bfe_u32 v16, v49, 2, 1
  v_mad_i32_i24 v34, v16, s47, v34
  v_lshl_add_u32 v49, v49, 2, s46
  s_mov_b64 exec, s[82:83]
  ds_write_b32 v49, v34
  ds_write_b32 v49, v35 offset:8064
  s_mov_b64 exec, -1
  v_add_u32 v50, v50, v66
  v_bfe_u32 v16, v50, 2, 1
  v_mad_i32_i24 v36, v16, s47, v36
  v_lshl_add_u32 v50, v50, 2, s46
  s_mov_b64 exec, s[84:85]
  ds_write_b32 v50, v36
  ds_write_b32 v50, v37 offset:8064
  s_mov_b64 exec, -1
  v_add_u32 v51, v51, v67
  v_bfe_u32 v16, v51, 2, 1
  v_mad_i32_i24 v38, v16, s47, v38
  v_lshl_add_u32 v51, v51, 2, s46
  s_mov_b64 exec, s[86:87]
  ds_write_b32 v51, v38
  ds_write_b32 v51, v39 offset:8064
  s_mov_b64 exec, -1
  v_cmp_lt_i32 vcc, 16, v23
  s_cbranch_vccz F_pos_done
  ds_bpermute_b32 v52, v52, v20
  ds_bpermute_b32 v53, v53, v20
  ds_bpermute_b32 v54, v54, v20
  ds_bpermute_b32 v55, v55, v20
  s_waitcnt lgkmcnt(0)
  v_add_u32 v52, v52, v68
  v_bfe_u32 v16, v52, 2, 1
  v_mad_i32_i24 v40, v16, s47, v40
  v_lshl_add_u32 v52, v52, 2, s46
  v_cmp_lt_i32 vcc, 16, v23
  s_mov_b64 exec, vcc
  ds_write_b32 v52, v40
  ds_write_b32 v52, v41 offset:8064
  s_mov_b64 exec, -1
  v_add_u32 v53, v53, v69
  v_bfe_u32 v16, v53, 2, 1
  v_mad_i32_i24 v42, v16, s47, v42
  v_lshl_add_u32 v53, v53, 2, s46
  v_cmp_lt_i32 vcc, 17, v23
  s_mov_b64 exec, vcc
  ds_write_b32 v53, v42
  ds_write_b32 v53, v43 offset:8064
  s_mov_b64 exec, -1
  v_add_u32 v54, v54, v70
  v_bfe_u32 v16, v54, 2, 1
  v_mad_i32_i24 v44, v16, s47, v44
  v_lshl_add_u32 v54, v54, 2, s46
  v_cmp_lt_i32 vcc, 24, v23
  s_mov_b64 exec, vcc
  ds_write_b32 v54, v44
  ds_write_b32 v54, v45 offset:8064
  s_mov_b64 exec, -1
  v_add_u32 v55, v55, v71
  v_bfe_u32 v16, v55, 2, 1
  v_mad_i32_i24 v46, v16, s47, v46
  v_lshl_add_u32 v55, v55, 2, s46
  v_cmp_lt_i32 vcc, 25, v23
  s_mov_b64 exec, vcc
  ds_write_b32 v55, v46
  ds_write_b32 v55, v47 offset:8064
  s_mov_b64 exec, -1
F_pos_done:
  s_lshl_b32 s65, s91, 7
  s_add_u32 s65, s65, 136192
  s_mov_b32 s69, s65
  s_and_b32 s68, s20, 3
  s_lshr_b32 s67, s20, 2
  s_lshl_b32 s67, s67, 10
  s_add_u32 s67, s67, 4096
  s_mov_b32 s44, s88
  s_mov_b32 s45, s91
  s_mov_b32 s46, s64
  s_sub_u32 s58, s44, 1
  s_bfe_u32 s21, s58, 0x20003
  s_add_u32 s21, s21, 1
  s_cmp_gt_u32 s21, 3
  s_cselect_b32 s58, 0, s64
  s_sub_u32 s66, s58, 1
  s_and_b32 s58, s44, 31
  s_cbranch_scc0 K2_nopad
  s_cmp_lg_u32 s68, 3
  s_cbranch_scc1 K2_nopad
  v_and_b32 v16, 31, v108
  v_cmp_le_u32 vcc, s58, v16
  s_add_u32 s59, s45, s46
  s_sub_u32 s59, s59, 1
  s_lshl_b32 s59, s59, 7
  s_add_u32 s59, s59, 136192
  s_mul_i32 s58, s2, 50176
  v_and_b32 v17, 4, v16
  v_lshlrev_b32 v17, 5, v17
  v_sub_u32 v17, 128, v17
  v_add_u32 v17, s58, v17
  v_lshl_add_u32 v18, v16, 2, s59
  v_mov_b32 v19, 25
  s_and_saveexec_b64 s[46:47], vcc
  ds_write_b32 v18, v17
  ds_write_b32 v18, v19 offset:8064
  s_mov_b64 exec, s[46:47]
K2_nopad:
  s_waitcnt lgkmcnt(0)
  s_barrier
  s_mov_b32 s62, 0
  s_cmp_gt_u32 s68, 0
  s_cbranch_scc1 H_pe0
  s_add_u32 s46, s62, 0
  s_cmp_ge_u32 s46, s64
  s_cbranch_scc1 H_pe0
  s_lshl_b32 s44, s46, 7
  s_add_u32 s44, s44, s69
  v_add_u32 v127, s44, v122
  ds_read_b32 v126, v127
  s_and_b32 s45, s46, 15
  s_lshl_b32 s45, s45, 12
  s_add_u32 s44, s67, s45
  s_mov_b32 m0, s44
  s_waitcnt lgkmcnt(0)
  v_and_or_b32 v127, v126, s18, v118
  buffer_load_dwordx4 v127, s[12:15], 0 offen lds
H_pe0:
  s_cmp_gt_u32 s68, 0
  s_cbranch_scc1 H_pe1
  s_add_u32 s46, s62, 1
  s_cmp_ge_u32 s46, s64
  s_cbranch_scc1 H_pe1
  s_lshl_b32 s44, s46, 7
  s_add_u32 s44, s44, s69
  v_add_u32 v127, s44, v122
  ds_read_b32 v126, v127
  s_and_b32 s45, s46, 15
  s_lshl_b32 s45, s45, 12
  s_add_u32 s44, s67, s45
  s_mov_b32 m0, s44
  s_waitcnt lgkmcnt(0)
  v_and_or_b32 v127, v126, s18, v118
  buffer_load_dwordx4 v127, s[12:15], 0 offen lds
H_pe1:
  s_cmp_gt_u32 s68, 0
  s_cbranch_scc1 H_pe2
  s_add_u32 s46, s62, 2
  s_cmp_ge_u32 s46, s64
  s_cbranch_scc1 H_pe2
  s_lshl_b32 s44, s46, 7
  s_add_u32 s44, s44, s69
  v_add_u32 v127, s44, v122
  ds_read_b32 v126, v127
  s_and_b32 s45, s46, 15
  s_lshl_b32 s45, s45, 12
  s_add_u32 s44, s67, s45
  s_mov_b32 m0, s44
  s_waitcnt lgkmcnt(0)
  v_and_or_b32 v127, v126, s18, v118
  buffer_load_dwordx4 v127, s[12:15], 0 offen lds
H_pe2:
  s_cmp_gt_u32 s68, 0
  s_cbranch_scc1 H_pe3
  s_add_u32 s46, s62, 3
  s_cmp_ge_u32 s46, s64
  s_cbranch_scc1 H_pe3
  s_lshl_b32 s44, s46, 7
  s_add_u32 s44, s44, s69
  v_add_u32 v127, s44, v122
  ds_read_b32 v126, v127
  s_and_b32 s45, s46, 15
  s_lshl_b32 s45, s45, 12
  s_add_u32 s44, s67, s45
  s_mov_b32 m0, s44
  s_waitcnt lgkmcnt(0)
  v_and_or_b32 v127, v126, s18, v118
  buffer_load_dwordx4 v127, s[12:15], 0 offen lds
H_pe3:
  s_cmp_gt_u32 s68, 0
  s_cbranch_scc1 H_pe4
  s_add_u32 s46, s62, 4
  s_cmp_ge_u32 s46, s64
  s_cbranch_scc1 H_pe4
  s_lshl_b32 s44, s46, 7
  s_add_u32 s44, s44, s69
  v_add_u32 v127, s44, v122
  ds_read_b32 v126, v127
  s_and_b32 s45, s46, 15
  s_lshl_b32 s45, s45, 12
  s_add_u32 s44, s67, s45
  s_mov_b32 m0, s44
  s_waitcnt lgkmcnt(0)
  v_and_or_b32 v127, v126, s18, v118
  buffer_load_dwordx4 v127, s[12:15], 0 offen lds
H_pe4:
  s_add_u32 s46, s62, 0
  s_cmp_ge_u32 s46, s64
  s_cbranch_scc1 H_pg0
  v_add_u32 v127, s65, v118
  ds_read_b128 v[64:67], v127 offset:0
  ds_read_b128 v[68:71], v127 offset:32
  ds_read_b128 v[72:75], v127 offset:64
  ds_read_b128 v[76:79], v127 offset:96
  v_add_u32 v127, s65, v122
  ds_read_b32 v116, v127
  s_add_u32 s65, s65, 128
  s_waitcnt lgkmcnt(4)
  buffer_load_dword v16, v64, s[8:11], 0 offen sc1
  buffer_load_dword v17, v65, s[8:11], 0 offen sc1
  buffer_load_dword v18, v66, s[8:11], 0 offen sc1
  buffer_load_dword v19, v67, s[8:11], 0 offen sc1
  s_waitcnt lgkmcnt(3)
  buffer_load_dword v20, v68, s[8:11], 0 offen sc1
  buffer_load_dword v21, v69, s[8:11], 0 offen sc1
  buffer_load_dword v22, v70, s[8:11], 0 offen sc1
  buffer_load_dword v23, v71, s[8:11], 0 offen sc1
  s_waitcnt lgkmcnt(2)
  buffer_load_dword v24, v72, s[8:11], 0 offen sc1
  buffer_load_dword v25, v73, s[8:11], 0 offen sc1
  buffer_load_dword v26, v74, s[8:11], 0 offen sc1
  buffer_load_dword v27, v75, s[8:11], 0 offen sc1
  s_waitcnt lgkmcnt(1)
  buffer_load_dword v28, v76, s[8:11], 0 offen sc1
  buffer_load_dword v29, v77, s[8:11], 0 offen sc1
  buffer_load_dword v30, v78, s[8:11], 0 offen sc1
  buffer_load_dword v31, v79, s[8:11], 0 offen sc1
H_pg0:
  s_barrier
  s_cmp_gt_u32 s68, 0
  s_cbranch_scc1 H_pel
  s_add_u32 s46, s62, 5
  s_cmp_ge_u32 s46, s64
  s_cbranch_scc1 H_pel
  s_lshl_b32 s44, s46, 7
  s_add_u32 s44, s44, s69
  v_add_u32 v127, s44, v122
  ds_read_b32 v126, v127
  s_and_b32 s45, s46, 15
  s_lshl_b32 s45, s45, 12
  s_add_u32 s44, s67, s45
  s_mov_b32 m0, s44
  s_waitcnt lgkmcnt(0)
  v_and_or_b32 v127, v126, s18, v118
  buffer_load_dwordx4 v127, s[12:15], 0 offen lds
H_pel:
  s_add_u32 s46, s62, 1
  s_cmp_ge_u32 s46, s64
  s_cbranch_scc1 H_pg1
  v_add_u32 v127, s65, v118
  ds_read_b128 v[64:67], v127 offset:0
  ds_read_b128 v[68:71], v127 offset:32
  ds_read_b128 v[72:75], v127 offset:64
  ds_read_b128 v[76:79], v127 offset:96
  v_add_u32 v127, s65, v122
  ds_read_b32 v117, v127
  s_add_u32 s65, s65, 128
  s_waitcnt lgkmcnt(4)
  buffer_load_dword v32, v64, s[8:11], 0 offen sc1
  buffer_load_dword v33, v65, s[8:11], 0 offen sc1
  buffer_load_dword v34, v66, s[8:11], 0 offen sc1
  buffer_load_dword v35, v67, s[8:11], 0 offen sc1
  s_waitcnt lgkmcnt(3)
  buffer_load_dword v36, v68, s[8:11], 0 offen sc1
  buffer_load_dword v37, v69, s[8:11], 0 offen sc1
  buffer_load_dword v38, v70, s[8:11], 0 offen sc1
  buffer_load_dword v39, v71, s[8:11], 0 offen sc1
  s_waitcnt lgkmcnt(2)
  buffer_load_dword v40, v72, s[8:11], 0 offen sc1
  buffer_load_dword v41, v73, s[8:11], 0 offen sc1
  buffer_load_dword v42, v74, s[8:11], 0 offen sc1
  buffer_load_dword v43, v75, s[8:11], 0 offen sc1
  s_waitcnt lgkmcnt(1)
  buffer_load_dword v44, v76, s[8:11], 0 offen sc1
  buffer_load_dword v45, v77, s[8:11], 0 offen sc1
  buffer_load_dword v46, v78, s[8:11], 0 offen sc1
  buffer_load_dword v47, v79, s[8:11], 0 offen sc1
H_pg1:
  s_mov_b32 s60, 0
  s_waitcnt vmcnt(33)
  s_cmp_le_u32 s68, 0
  s_cbranch_scc1 H_pw
  s_waitcnt vmcnt(32)
H_pw:
  s_cmp_ge_u32 s64, 6
  s_cbranch_scc1 H_loop
  s_waitcnt vmcnt(0)
.p2align 3
H_loop:
  s_waitcnt lgkmcnt(0)
  s_and_b32 s44, s62, 2
  s_cbranch_scc1 H_p10
  s_barrier
  s_setprio 3
  s_branch H_p20
H_p10:
  s_setprio 1
H_p20:
  s_cmp_ge_u32 s62, s64
  s_cbranch_scc1 H_idle0
  v_and_b32 v126, 31, v116
  v_mad_u32_u24 v127, v126, s17, v118
  v_mad_u32_u24 v126, v126, s17, v119
  ds_read_b128 v[100:103], v127 offset:0
  ds_read_b128 v[104:107], v127 offset:32
  s_and_b32 s45, s62, 15
  s_lshl_b32 s45, s45, 12
  s_add_u32 s44, s67, s45
  v_add_u32 v127, s44, v123
  ds_read_b128 v[92:95], v127
  s_waitcnt vmcnt(17)
  s_add_u32 s44, s62, 5
  s_cmp_lt_u32 s44, s64
  s_cselect_b32 s45, s68, 3
  s_cmp_le_u32 s45, 0
  s_cbranch_scc1 H_go0
  s_waitcnt vmcnt(16)
  s_add_u32 s44, s62, 1
  s_cmp_lt_u32 s44, s64
  s_cbranch_scc1 H_go0
  s_waitcnt vmcnt(0)
H_go0:
  s_waitcnt lgkmcnt(0)
  v_mfma_f32_32x32x16_bf16 v[48:63], v[92:95], v[88:91], v[16:31]
  v_mfma_f32_32x32x16_bf16 v[48:63], v[100:103], v[80:83], v[48:63]
  v_mfma_f32_32x32x16_bf16 v[48:63], v[104:107], v[84:87], v[48:63]
  ds_write_b16_d16_hi v126, v121
  ds_read_b128 v[100:103], v120
  ds_read_b128 v[104:107], v120 offset:32
  ds_write_b16 v126, v121
  s_cmp_eq_u32 s62, s66
  s_cbranch_scc0 H_full0
  v_mov_b32 v110, 0
  v_mov_b32 v111, 0
  v_mov_b32 v112, 0
  v_mov_b32 v113, 0
  v_mov_b32 v114, 0
  v_mov_b32 v115, 0
  v_lshlrev_b32 v16, 16, v16
  v_lshlrev_b32 v17, 16, v17
  v_lshlrev_b32 v18, 16, v18
  v_lshlrev_b32 v19, 16, v19
  v_exp_f32 v48, v48
  v_exp_f32 v49, v49
  v_exp_f32 v50, v50
  v_exp_f32 v51, v51
  v_add_f32 v48, 1.0, v48
  v_add_f32 v49, 1.0, v49
  v_add_f32 v50, 1.0, v50
  v_add_f32 v51, 1.0, v51
  v_rcp_f32 v48, v48
  v_rcp_f32 v49, v49
  v_rcp_f32 v50, v50
  v_rcp_f32 v51, v51
  v_mul_f32 v48, v48, v16
  v_mul_f32 v49, v49, v17
  v_mul_f32 v50, v50, v18
  v_mul_f32 v51, v51, v19
  v_cvt_pk_bf16_f32 v108, v48, v49
  v_cvt_pk_bf16_f32 v109, v50, v51
  s_cmp_le_u32 s21, 1
  s_cbranch_scc1 H_lq0
  v_lshlrev_b32 v20, 16, v20
  v_lshlrev_b32 v21, 16, v21
  v_lshlrev_b32 v22, 16, v22
  v_lshlrev_b32 v23, 16, v23
  v_exp_f32 v52, v52
  v_exp_f32 v53, v53
  v_exp_f32 v54, v54
  v_exp_f32 v55, v55
  v_add_f32 v52, 1.0, v52
  v_add_f32 v53, 1.0, v53
  v_add_f32 v54, 1.0, v54
  v_add_f32 v55, 1.0, v55
  v_rcp_f32 v52, v52
  v_rcp_f32 v53, v53
  v_rcp_f32 v54, v54
  v_rcp_f32 v55, v55
  v_mul_f32 v52, v52, v20
  v_mul_f32 v53, v53, v21
  v_mul_f32 v54, v54, v22
  v_mul_f32 v55, v55, v23
  v_cvt_pk_bf16_f32 v110, v52, v53
  v_cvt_pk_bf16_f32 v111, v54, v55
  s_cmp_le_u32 s21, 2
  s_cbranch_scc1 H_lq0
  v_lshlrev_b32 v24, 16, v24
  v_lshlrev_b32 v25, 16, v25
  v_lshlrev_b32 v26, 16, v26
  v_lshlrev_b32 v27, 16, v27
  v_exp_f32 v56, v56
  v_exp_f32 v57, v57
  v_exp_f32 v58, v58
  v_exp_f32 v59, v59
  v_add_f32 v56, 1.0, v56
  v_add_f32 v57, 1.0, v57
  v_add_f32 v58, 1.0, v58
  v_add_f32 v59, 1.0, v59
  v_rcp_f32 v56, v56
  v_rcp_f32 v57, v57
  v_rcp_f32 v58, v58
  v_rcp_f32 v59, v59
  v_mul_f32 v56, v56, v24
  v_mul_f32 v57, v57, v25
  v_mul_f32 v58, v58, v26
  v_mul_f32 v59, v59, v27
  v_cvt_pk_bf16_f32 v112, v56, v57
  v_cvt_pk_bf16_f32 v113, v58, v59
H_lq0:
  s_waitcnt lgkmcnt(0)
  s_nop 0
  v_mfma_f32_32x32x16_bf16 v[0:15], v[100:103], v[108:111], v[0:15]
  v_mfma_f32_32x32x16_bf16 v[0:15], v[104:107], v[112:115], v[0:15]
  s_branch H_idle0
H_full0:
  v_lshlrev_b32 v16, 16, v16
  v_lshlrev_b32 v17, 16, v17
  v_lshlrev_b32 v18, 16, v18
  v_lshlrev_b32 v19, 16, v19
  v_lshlrev_b32 v20, 16, v20
  v_lshlrev_b32 v21, 16, v21
  v_lshlrev_b32 v22, 16, v22
  v_lshlrev_b32 v23, 16, v23
  v_lshlrev_b32 v24, 16, v24
  v_lshlrev_b32 v25, 16, v25
  v_lshlrev_b32 v26, 16, v26
  v_lshlrev_b32 v27, 16, v27
  v_lshlrev_b32 v28, 16, v28
  v_lshlrev_b32 v29, 16, v29
  v_lshlrev_b32 v30, 16, v30
  v_lshlrev_b32 v31, 16, v31
  v_exp_f32 v48, v48
  v_exp_f32 v49, v49
  v_exp_f32 v50, v50
  v_exp_f32 v51, v51
  v_exp_f32 v52, v52
  v_exp_f32 v53, v53
  v_exp_f32 v54, v54
  v_exp_f32 v55, v55
  v_exp_f32 v56, v56
  v_exp_f32 v57, v57
  v_exp_f32 v58, v58
  v_exp_f32 v59, v59
  v_exp_f32 v60, v60
  v_exp_f32 v61, v61
  v_exp_f32 v62, v62
  v_exp_f32 v63, v63
  v_add_f32 v48, 1.0, v48
  v_add_f32 v49, 1.0, v49
  v_add_f32 v50, 1.0, v50
  v_add_f32 v51, 1.0, v51
  v_add_f32 v52, 1.0, v52
  v_add_f32 v53, 1.0, v53
  v_add_f32 v54, 1.0, v54
  v_add_f32 v55, 1.0, v55
  v_add_f32 v56, 1.0, v56
  v_add_f32 v57, 1.0, v57
  v_add_f32 v58, 1.0, v58
  v_add_f32 v59, 1.0, v59
  v_add_f32 v60, 1.0, v60
  v_add_f32 v61, 1.0, v61
  v_add_f32 v62, 1.0, v62
  v_add_f32 v63, 1.0, v63
  v_rcp_f32 v48, v48
  v_rcp_f32 v49, v49
  v_rcp_f32 v50, v50
  v_rcp_f32 v51, v51
  v_rcp_f32 v52, v52
  v_rcp_f32 v53, v53
  v_rcp_f32 v54, v54
  v_rcp_f32 v55, v55
  v_rcp_f32 v56, v56
  v_rcp_f32 v57, v57
  v_rcp_f32 v58, v58
  v_rcp_f32 v59, v59
  v_rcp_f32 v60, v60
  v_rcp_f32 v61, v61
  v_rcp_f32 v62, v62
  v_rcp_f32 v63, v63
  v_mul_f32 v48, v48, v16
  v_mul_f32 v49, v49, v17
  v_mul_f32 v50, v50, v18
  v_mul_f32 v51, v51, v19
  v_mul_f32 v52, v52, v20
  v_mul_f32 v53, v53, v21
  v_mul_f32 v54, v54, v22
  v_mul_f32 v55, v55, v23
  v_mul_f32 v56, v56, v24
  v_mul_f32 v57, v57, v25
  v_mul_f32 v58, v58, v26
  v_mul_f32 v59, v59, v27
  v_mul_f32 v60, v60, v28
  v_mul_f32 v61, v61, v29
  v_mul_f32 v62, v62, v30
  v_mul_f32 v63, v63, v31
  v_cvt_pk_bf16_f32 v108, v48, v49
  v_cvt_pk_bf16_f32 v109, v50, v51
  v_cvt_pk_bf16_f32 v110, v52, v53
  v_cvt_pk_bf16_f32 v111, v54, v55
  v_cvt_pk_bf16_f32 v112, v56, v57
  v_cvt_pk_bf16_f32 v113, v58, v59
  v_cvt_pk_bf16_f32 v114, v60, v61
  v_cvt_pk_bf16_f32 v115, v62, v63
  s_waitcnt lgkmcnt(0)
  s_nop 0
  v_mfma_f32_32x32x16_bf16 v[0:15], v[100:103], v[108:111], v[0:15]
  v_mfma_f32_32x32x16_bf16 v[0:15], v[104:107], v[112:115], v[0:15]
  s_cmp_gt_u32 s68, 0
  s_cbranch_scc1 H_fe0
  s_add_u32 s46, s62, 6
  s_cmp_ge_u32 s46, s64
  s_cbranch_scc1 H_fe0
  s_lshl_b32 s44, s46, 7
  s_add_u32 s44, s44, s69
  v_add_u32 v127, s44, v122
  ds_read_b32 v126, v127
  s_and_b32 s45, s46, 15
  s_lshl_b32 s45, s45, 12
  s_add_u32 s44, s67, s45
  s_mov_b32 m0, s44
  s_waitcnt lgkmcnt(0)
  v_and_or_b32 v127, v126, s18, v118
  buffer_load_dwordx4 v127, s[12:15], 0 offen lds
H_fe0:
  s_add_u32 s46, s62, 2
  s_cmp_ge_u32 s46, s64
  s_cbranch_scc1 H_fg0
  v_add_u32 v127, s65, v118
  ds_read_b128 v[64:67], v127 offset:0
  ds_read_b128 v[68:71], v127 offset:32
  ds_read_b128 v[72:75], v127 offset:64
  ds_read_b128 v[76:79], v127 offset:96
  v_add_u32 v127, s65, v122
  ds_read_b32 v116, v127
  s_add_u32 s65, s65, 128
  s_waitcnt lgkmcnt(4)
  buffer_load_dword v16, v64, s[8:11], 0 offen sc1
  buffer_load_dword v17, v65, s[8:11], 0 offen sc1
  buffer_load_dword v18, v66, s[8:11], 0 offen sc1
  buffer_load_dword v19, v67, s[8:11], 0 offen sc1
  s_waitcnt lgkmcnt(3)
  buffer_load_dword v20, v68, s[8:11], 0 offen sc1
  buffer_load_dword v21, v69, s[8:11], 0 offen sc1
  buffer_load_dword v22, v70, s[8:11], 0 offen sc1
  buffer_load_dword v23, v71, s[8:11], 0 offen sc1
  s_waitcnt lgkmcnt(2)
  buffer_load_dword v24, v72, s[8:11], 0 offen sc1
  buffer_load_dword v25, v73, s[8:11], 0 offen sc1
  buffer_load_dword v26, v74, s[8:11], 0 offen sc1
  buffer_load_dword v27, v75, s[8:11], 0 offen sc1
  s_waitcnt lgkmcnt(1)
  buffer_load_dword v28, v76, s[8:11], 0 offen sc1
  buffer_load_dword v29, v77, s[8:11], 0 offen sc1
  buffer_load_dword v30, v78, s[8:11], 0 offen sc1
  buffer_load_dword v31, v79, s[8:11], 0 offen sc1
H_fg0:
H_idle0:
  s_add_u32 s62, s62, 1
  s_cmp_ge_u32 s62, s63
  s_cbranch_scc1 H_done
  s_waitcnt lgkmcnt(0)
  s_and_b32 s44, s62, 2
  s_cbranch_scc1 H_p11
  s_setprio 2
  s_branch H_p21
H_p11:
  s_setprio 0
H_p21:
  s_cmp_ge_u32 s62, s64
  s_cbranch_scc1 H_idle1
  v_and_b32 v126, 31, v117
  v_mad_u32_u24 v127, v126, s17, v118
  v_mad_u32_u24 v126, v126, s17, v119
  ds_read_b128 v[100:103], v127 offset:0
  ds_read_b128 v[104:107], v127 offset:32
  s_and_b32 s45, s62, 15
  s_lshl_b32 s45, s45, 12
  s_add_u32 s44, s67, s45
  v_add_u32 v127, s44, v123
  ds_read_b128 v[92:95], v127
  s_waitcnt vmcnt(17)
  s_add_u32 s44, s62, 5
  s_cmp_lt_u32 s44, s64
  s_cselect_b32 s45, s68, 3
  s_cmp_le_u32 s45, 0
  s_cbranch_scc1 H_go1
  s_waitcnt vmcnt(16)
  s_add_u32 s44, s62, 1
  s_cmp_lt_u32 s44, s64
  s_cbranch_scc1 H_go1
  s_waitcnt vmcnt(0)
H_go1:
  s_waitcnt lgkmcnt(0)
  v_mfma_f32_32x32x16_bf16 v[48:63], v[92:95], v[88:91], v[32:47]
  v_mfma_f32_32x32x16_bf16 v[48:63], v[100:103], v[80:83], v[48:63]
  v_mfma_f32_32x32x16_bf16 v[48:63], v[104:107], v[84:87], v[48:63]
  ds_write_b16_d16_hi v126, v121
  ds_read_b128 v[100:103], v120
  ds_read_b128 v[104:107], v120 offset:32
  ds_write_b16 v126, v121
  s_cmp_eq_u32 s62, s66
  s_cbranch_scc0 H_full1
  v_mov_b32 v110, 0
  v_mov_b32 v111, 0
  v_mov_b32 v112, 0
  v_mov_b32 v113, 0
  v_mov_b32 v114, 0
  v_mov_b32 v115, 0
  v_lshlrev_b32 v32, 16, v32
  v_lshlrev_b32 v33, 16, v33
  v_lshlrev_b32 v34, 16, v34
  v_lshlrev_b32 v35, 16, v35
  v_exp_f32 v48, v48
  v_exp_f32 v49, v49
  v_exp_f32 v50, v50
  v_exp_f32 v51, v51
  v_add_f32 v48, 1.0, v48
  v_add_f32 v49, 1.0, v49
  v_add_f32 v50, 1.0, v50
  v_add_f32 v51, 1.0, v51
  v_rcp_f32 v48, v48
  v_rcp_f32 v49, v49
  v_rcp_f32 v50, v50
  v_rcp_f32 v51, v51
  v_mul_f32 v48, v48, v32
  v_mul_f32 v49, v49, v33
  v_mul_f32 v50, v50, v34
  v_mul_f32 v51, v51, v35
  v_cvt_pk_bf16_f32 v108, v48, v49
  v_cvt_pk_bf16_f32 v109, v50, v51
  s_cmp_le_u32 s21, 1
  s_cbranch_scc1 H_lq1
  v_lshlrev_b32 v36, 16, v36
  v_lshlrev_b32 v37, 16, v37
  v_lshlrev_b32 v38, 16, v38
  v_lshlrev_b32 v39, 16, v39
  v_exp_f32 v52, v52
  v_exp_f32 v53, v53
  v_exp_f32 v54, v54
  v_exp_f32 v55, v55
  v_add_f32 v52, 1.0, v52
  v_add_f32 v53, 1.0, v53
  v_add_f32 v54, 1.0, v54
  v_add_f32 v55, 1.0, v55
  v_rcp_f32 v52, v52
  v_rcp_f32 v53, v53
  v_rcp_f32 v54, v54
  v_rcp_f32 v55, v55
  v_mul_f32 v52, v52, v36
  v_mul_f32 v53, v53, v37
  v_mul_f32 v54, v54, v38
  v_mul_f32 v55, v55, v39
  v_cvt_pk_bf16_f32 v110, v52, v53
  v_cvt_pk_bf16_f32 v111, v54, v55
  s_cmp_le_u32 s21, 2
  s_cbranch_scc1 H_lq1
  v_lshlrev_b32 v40, 16, v40
  v_lshlrev_b32 v41, 16, v41
  v_lshlrev_b32 v42, 16, v42
  v_lshlrev_b32 v43, 16, v43
  v_exp_f32 v56, v56
  v_exp_f32 v57, v57
  v_exp_f32 v58, v58
  v_exp_f32 v59, v59
  v_add_f32 v56, 1.0, v56
  v_add_f32 v57, 1.0, v57
  v_add_f32 v58, 1.0, v58
  v_add_f32 v59, 1.0, v59
  v_rcp_f32 v56, v56
  v_rcp_f32 v57, v57
  v_rcp_f32 v58, v58
  v_rcp_f32 v59, v59
  v_mul_f32 v56, v56, v40
  v_mul_f32 v57, v57, v41
  v_mul_f32 v58, v58, v42
  v_mul_f32 v59, v59, v43
  v_cvt_pk_bf16_f32 v112, v56, v57
  v_cvt_pk_bf16_f32 v113, v58, v59
H_lq1:
  s_waitcnt lgkmcnt(0)
  s_nop 0
  v_mfma_f32_32x32x16_bf16 v[0:15], v[100:103], v[108:111], v[0:15]
  v_mfma_f32_32x32x16_bf16 v[0:15], v[104:107], v[112:115], v[0:15]
  s_branch H_idle1
H_full1:
  v_lshlrev_b32 v32, 16, v32
  v_lshlrev_b32 v33, 16, v33
  v_lshlrev_b32 v34, 16, v34
  v_lshlrev_b32 v35, 16, v35
  v_lshlrev_b32 v36, 16, v36
  v_lshlrev_b32 v37, 16, v37
  v_lshlrev_b32 v38, 16, v38
  v_lshlrev_b32 v39, 16, v39
  v_lshlrev_b32 v40, 16, v40
  v_lshlrev_b32 v41, 16, v41
  v_lshlrev_b32 v42, 16, v42
  v_lshlrev_b32 v43, 16, v43
  v_lshlrev_b32 v44, 16, v44
  v_lshlrev_b32 v45, 16, v45
  v_lshlrev_b32 v46, 16, v46
  v_lshlrev_b32 v47, 16, v47
  v_exp_f32 v48, v48
  v_exp_f32 v49, v49
  v_exp_f32 v50, v50
  v_exp_f32 v51, v51
  v_exp_f32 v52, v52
  v_exp_f32 v53, v53
  v_exp_f32 v54, v54
  v_exp_f32 v55, v55
  v_exp_f32 v56, v56
  v_exp_f32 v57, v57
  v_exp_f32 v58, v58
  v_exp_f32 v59, v59
  v_exp_f32 v60, v60
  v_exp_f32 v61, v61
  v_exp_f32 v62, v62
  v_exp_f32 v63, v63
  v_add_f32 v48, 1.0, v48
  v_add_f32 v49, 1.0, v49
  v_add_f32 v50, 1.0, v50
  v_add_f32 v51, 1.0, v51
  v_add_f32 v52, 1.0, v52
  v_add_f32 v53, 1.0, v53
  v_add_f32 v54, 1.0, v54
  v_add_f32 v55, 1.0, v55
  v_add_f32 v56, 1.0, v56
  v_add_f32 v57, 1.0, v57
  v_add_f32 v58, 1.0, v58
  v_add_f32 v59, 1.0, v59
  v_add_f32 v60, 1.0, v60
  v_add_f32 v61, 1.0, v61
  v_add_f32 v62, 1.0, v62
  v_add_f32 v63, 1.0, v63
  v_rcp_f32 v48, v48
  v_rcp_f32 v49, v49
  v_rcp_f32 v50, v50
  v_rcp_f32 v51, v51
  v_rcp_f32 v52, v52
  v_rcp_f32 v53, v53
  v_rcp_f32 v54, v54
  v_rcp_f32 v55, v55
  v_rcp_f32 v56, v56
  v_rcp_f32 v57, v57
  v_rcp_f32 v58, v58
  v_rcp_f32 v59, v59
  v_rcp_f32 v60, v60
  v_rcp_f32 v61, v61
  v_rcp_f32 v62, v62
  v_rcp_f32 v63, v63
  v_mul_f32 v48, v48, v32
  v_mul_f32 v49, v49, v33
  v_mul_f32 v50, v50, v34
  v_mul_f32 v51, v51, v35
  v_mul_f32 v52, v52, v36
  v_mul_f32 v53, v53, v37
  v_mul_f32 v54, v54, v38
  v_mul_f32 v55, v55, v39
  v_mul_f32 v56, v56, v40
  v_mul_f32 v57, v57, v41
  v_mul_f32 v58, v58, v42
  v_mul_f32 v59, v59, v43
  v_mul_f32 v60, v60, v44
  v_mul_f32 v61, v61, v45
  v_mul_f32 v62, v62, v46
  v_mul_f32 v63, v63, v47
  v_cvt_pk_bf16_f32 v108, v48, v49
  v_cvt_pk_bf16_f32 v109, v50, v51
  v_cvt_pk_bf16_f32 v110, v52, v53
  v_cvt_pk_bf16_f32 v111, v54, v55
  v_cvt_pk_bf16_f32 v112, v56, v57
  v_cvt_pk_bf16_f32 v113, v58, v59
  v_cvt_pk_bf16_f32 v114, v60, v61
  v_cvt_pk_bf16_f32 v115, v62, v63
  s_waitcnt lgkmcnt(0)
  s_nop 0
  v_mfma_f32_32x32x16_bf16 v[0:15], v[100:103], v[108:111], v[0:15]
  v_mfma_f32_32x32x16_bf16 v[0:15], v[104:107], v[112:115], v[0:15]
  s_cmp_gt_u32 s68, 0
  s_cbranch_scc1 H_fe1
  s_add_u32 s46, s62, 6
  s_cmp_ge_u32 s46, s64
  s_cbranch_scc1 H_fe1
  s_lshl_b32 s44, s46, 7
  s_add_u32 s44, s44, s69
  v_add_u32 v127, s44, v122
  ds_read_b32 v126, v127
  s_and_b32 s45, s46, 15
  s_lshl_b32 s45, s45, 12
  s_add_u32 s44, s67, s45
  s_mov_b32 m0, s44
  s_waitcnt lgkmcnt(0)
  v_and_or_b32 v127, v126, s18, v118
  buffer_load_dwordx4 v127, s[12:15], 0 offen lds
H_fe1:
  s_add_u32 s46, s62, 2
  s_cmp_ge_u32 s46, s64
  s_cbranch_scc1 H_fg1
  v_add_u32 v127, s65, v118
  ds_read_b128 v[64:67], v127 offset:0
  ds_read_b128 v[68:71], v127 offset:32
  ds_read_b128 v[72:75], v127 offset:64
  ds_read_b128 v[76:79], v127 offset:96
  v_add_u32 v127, s65, v122
  ds_read_b32 v117, v127
  s_add_u32 s65, s65, 128
  s_waitcnt lgkmcnt(4)
  buffer_load_dword v32, v64, s[8:11], 0 offen sc1
  buffer_load_dword v33, v65, s[8:11], 0 offen sc1
  buffer_load_dword v34, v66, s[8:11], 0 offen sc1
  buffer_load_dword v35, v67, s[8:11], 0 offen sc1
  s_waitcnt lgkmcnt(3)
  buffer_load_dword v36, v68, s[8:11], 0 offen sc1
  buffer_load_dword v37, v69, s[8:11], 0 offen sc1
  buffer_load_dword v38, v70, s[8:11], 0 offen sc1
  buffer_load_dword v39, v71, s[8:11], 0 offen sc1
  s_waitcnt lgkmcnt(2)
  buffer_load_dword v40, v72, s[8:11], 0 offen sc1
  buffer_load_dword v41, v73, s[8:11], 0 offen sc1
  buffer_load_dword v42, v74, s[8:11], 0 offen sc1
  buffer_load_dword v43, v75, s[8:11], 0 offen sc1
  s_waitcnt lgkmcnt(1)
  buffer_load_dword v44, v76, s[8:11], 0 offen sc1
  buffer_load_dword v45, v77, s[8:11], 0 offen sc1
  buffer_load_dword v46, v78, s[8:11], 0 offen sc1
  buffer_load_dword v47, v79, s[8:11], 0 offen sc1
H_fg1:
H_idle1:
  s_add_u32 s62, s62, 1
  s_cmp_ge_u32 s62, s63
  s_cbranch_scc0 H_loop
H_done:
  s_cmp_lg_u32 s23, 0
  s_cbranch_scc1 K2_round
  s_mul_i32 s44, s2, 98
  s_lshr_b32 s45, s20, 2
  s_add_u32 s44, s44, s45
  s_lshl_b32 s44, s44, 8
  s_and_b32 s46, s20, 3
  s_lshl_b32 s46, s46, 6
  s_add_u32 s44, s44, s46
  s_sub_u32 s44, s44, 4032
  v_lshlrev_b32 v16, 8, v118
  v_lshrrev_b32 v17, 1, v122
  v_add3_u32 v16, v16, v17, s44
  s_mov_b32 s47, 0xbfb8aa3b
  s_nop 4
  v_mul_f32 v48, s47, v0
  v_mul_f32 v49, s47, v1
  v_mul_f32 v50, s47, v2
  v_mul_f32 v51, s47, v3
  v_mul_f32 v52, s47, v4
  v_mul_f32 v53, s47, v5
  v_mul_f32 v54, s47, v6
  v_mul_f32 v55, s47, v7
  v_mul_f32 v56, s47, v8
  v_mul_f32 v57, s47, v9
  v_mul_f32 v58, s47, v10
  v_mul_f32 v59, s47, v11
  v_mul_f32 v60, s47, v12
  v_exp_f32 v48, v48
  v_exp_f32 v49, v49
  v_exp_f32 v50, v50
  v_exp_f32 v51, v51
  v_exp_f32 v52, v52
  v_exp_f32 v53, v53
  v_exp_f32 v54, v54
  v_exp_f32 v55, v55
  v_exp_f32 v56, v56
  v_exp_f32 v57, v57
  v_exp_f32 v58, v58
  v_exp_f32 v59, v59
  v_exp_f32 v60, v60
  v_add_f32 v48, 1.0, v48
  v_add_f32 v49, 1.0, v49
  v_add_f32 v50, 1.0, v50
  v_add_f32 v51, 1.0, v51
  v_add_f32 v52, 1.0, v52
  v_add_f32 v53, 1.0, v53
  v_add_f32 v54, 1.0, v54
  v_add_f32 v55, 1.0, v55
  v_add_f32 v56, 1.0, v56
  v_add_f32 v57, 1.0, v57
  v_add_f32 v58, 1.0, v58
  v_add_f32 v59, 1.0, v59
  v_add_f32 v60, 1.0, v60
  v_rcp_f32 v48, v48
  v_rcp_f32 v49, v49
  v_rcp_f32 v50, v50
  v_rcp_f32 v51, v51
  v_rcp_f32 v52, v52
  v_rcp_f32 v53, v53
  v_rcp_f32 v54, v54
  v_rcp_f32 v55, v55
  v_rcp_f32 v56, v56
  v_rcp_f32 v57, v57
  v_rcp_f32 v58, v58
  v_rcp_f32 v59, v59
  v_rcp_f32 v60, v60
  v_mul_f32 v48, v48, v0
  v_mul_f32 v49, v49, v1
  v_mul_f32 v50, v50, v2
  v_mul_f32 v51, v51, v3
  v_mul_f32 v52, v52, v4
  v_mul_f32 v53, v53, v5
  v_mul_f32 v54, v54, v6
  v_mul_f32 v55, v55, v7
  v_mul_f32 v56, v56, v8
  v_mul_f32 v57, v57, v9
  v_mul_f32 v58, v58, v10
  v_mul_f32 v59, v59, v11
  v_mul_f32 v60, v60, v12
  v_cvt_pk_bf16_f32 v48, v48, v49
  v_cvt_pk_bf16_f32 v50, v50, v51
  v_cvt_pk_bf16_f32 v52, v52, v53
  v_cvt_pk_bf16_f32 v54, v54, v55
  v_cvt_pk_bf16_f32 v56, v56, v57
  v_cvt_pk_bf16_f32 v58, v58, v59
  v_cvt_pk_bf16_f32 v60, v60, v60
  buffer_store_short v48, v16, s[52:55], 0 offen offset:0 sc1
  buffer_store_short_d16_hi v48, v16, s[52:55], 0 offen offset:1024 sc1
  buffer_store_short v50, v16, s[52:55], 0 offen offset:2048 sc1
  buffer_store_short_d16_hi v50, v16, s[52:55], 0 offen offset:3072 sc1
  v_add_u32 v16, 8192, v16
  buffer_store_short v52, v16, s[52:55], 0 offen offset:0 sc1
  buffer_store_short_d16_hi v52, v16, s[52:55], 0 offen offset:1024 sc1
  buffer_store_short v54, v16, s[52:55], 0 offen offset:2048 sc1
  buffer_store_short_d16_hi v54, v16, s[52:55], 0 offen offset:3072 sc1
  v_add_u32 v16, 8192, v16
  buffer_store_short v56, v16, s[52:55], 0 offen offset:0 sc1
  buffer_store_short_d16_hi v56, v16, s[52:55], 0 offen offset:1024 sc1
  buffer_store_short v58, v16, s[52:55], 0 offen offset:2048 sc1
  buffer_store_short_d16_hi v58, v16, s[52:55], 0 offen offset:3072 sc1
  s_cmp_ge_u32 s45, 2
  s_cbranch_scc1 K2_done
  s_mov_b32 exec_hi, 0
  v_add_u32 v16, 8192, v16
  buffer_store_short v60, v16, s[52:55], 0 offen offset:0 sc1
K2_done:
K2_exit:
  s_endpgm
.section .rodata,"a"
.p2align 6
.amdhsa_kernel gather_scatter__edge_featured_mpnn_egc__graph_kernel
.amdhsa_next_free_vgpr 128
.amdhsa_next_free_sgpr 102
.amdhsa_accum_offset 128
.amdhsa_group_segment_fixed_size 0
.amdhsa_kernarg_size 80
.amdhsa_user_sgpr_count 2
.amdhsa_user_sgpr_kernarg_segment_ptr 1
.amdhsa_system_sgpr_workgroup_id_x 1
.amdhsa_float_denorm_mode_32 3
.end_amdhsa_kernel
```
